```python
import torch

def _softmax(x, axis=-1):
    return torch.softmax(x, dim=axis)
def _gelu(x):
    return torch.nn.functional.gelu(x, approximate="tanh")
def _silu(x):
    return torch.nn.functional.silu(x)
def _sigmoid(x):
    return torch.sigmoid(x)
def _layernorm(x, axis=-1, eps=1e-5):
    m = x.mean(dim=axis, keepdim=True)
    v = x.var(dim=axis, keepdim=True, unbiased=False)
    return (x - m) / torch.sqrt(v + eps)
def _scatter_add(tgt, idx, src, axis=0):
    return tgt.clone().index_add_(axis, idx, src)
def _segment_sum(src, seg, n):
    out = torch.zeros((n,) + src.shape[1:], dtype=src.dtype)
    return out.index_add_(0, seg, src)
def _pad(x, pw):
    flat = tuple(v for pair in reversed(pw) for v in pair)
    return torch.nn.functional.pad(x, flat)

kernel_name = 'standalone__softmax_full_bidir__sampling'

def setup_inputs():

    _w = (lambda a: (lambda t: t.to(torch.bfloat16) if t.is_floating_point() else t)(torch.as_tensor(a)))
    B, H, Sq, Skv, Dh = 8, 16, 16, 2048, 256
    return {
        "q": _w((lambda *s: torch.randn(*s, dtype=torch.bfloat16) * 0.8)(B, H, Sq, Dh)),
        "k": _w((lambda *s: torch.randn(*s, dtype=torch.bfloat16) * 0.8)(B, H, Skv, Dh)),
        "v": _w((lambda *s: torch.randn(*s, dtype=torch.bfloat16) * 0.05)(B, H, Skv, Dh)),
    }

def reference(q, k, v):
    scale = q.shape[-1] ** -0.5
    scores = torch.einsum('bhqd,bhkd->bhqk', q, k) * scale
    attn = _softmax(scores, axis=-1)
    return torch.einsum('bhqk,bhkd->bhqd', attn, v)
```

```asm
; @launch grid=(256,1,1) block=(384,1,1) lds=131648
.amdgcn_target "amdgcn-amd-amdhsa--gfx950"
.text
.globl standalone__softmax_full_bidir__sampling_kernel
.p2align 8
.type standalone__softmax_full_bidir__sampling_kernel,@function
standalone__softmax_full_bidir__sampling_kernel:
    s_load_dwordx8 s[4:11], s[0:1], 0
    s_load_dwordx4 s[12:15], s[0:1], 32
    s_cmp_ge_u32 s2, 256
    s_cbranch_scc1 L_end
    v_lshrrev_b32 v31, 6, v0
    v_and_b32 v18, 15, v0
    v_bfe_u32 v19, v0, 4, 2
    v_readfirstlane_b32 s44, v31
    s_lshr_b32 s52, s2, 4
    s_xor_b32 s63, s2, s52
    s_and_b32 s63, s63, 7
    s_lshl3_add_u32 s63, s52, s63
    s_lshl_b32 s62, s63, 20
    s_bfe_u32 s49, s2, 0x10003
    s_cmp_eq_u32 s44, 0
    s_cbranch_scc1 L_loader
    v_lshlrev_b32 v33, 2, v31
    v_add_u32 v33, 131580, v33
    v_mov_b32 v22, 0
    ds_write2_b32 v33, v22, v22 offset0:4 offset1:8
    s_waitcnt lgkmcnt(0)
    s_barrier
    s_branch L_consumer
L_loader:
    s_setprio 3
    v_lshlrev_b32 v22, 2, v19
    v_xor_b32 v22, v22, v18
    v_lshlrev_b32 v23, 9, v19
    v_lshl_add_u32 v1, v22, 4, v23
    v_xor_b32 v2, 32, v1
    v_add_u32 v2, 1024, v2
    v_xor_b32 v3, 48, v1
    v_add_u32 v3, 2048, v3
    v_xor_b32 v4, 16, v1
    v_add_u32 v4, 3072, v4
    s_lshl_b32 s42, s49, 16
    s_mov_b32 s18, 0x100000
    s_mov_b32 s19, 0x20000
    s_mov_b32 m0, 0
    s_waitcnt lgkmcnt(0)
    s_add_u32 s16, s6, s62
    s_addc_u32 s17, s7, 0
    buffer_load_dwordx4 v1, s[16:19], s42 offen offset:0 nt lds
    buffer_load_dwordx4 v2, s[16:19], s42 offen offset:1024 nt lds
    buffer_load_dwordx4 v3, s[16:19], s42 offen offset:2048 nt lds
    buffer_load_dwordx4 v4, s[16:19], s42 offen offset:3072 nt lds
    v_mov_b32 v32, 131584
    s_lshl_b32 s63, s63, 13
    s_lshl_b32 s49, s49, 8
    s_xor_b32 s48, s49, 0x100
    s_mov_b32 s26, 0x2000
    s_mov_b32 s27, 0x20000
    s_add_u32 s24, s4, s63
    s_addc_u32 s25, s5, 0
    s_mov_b32 m0, 98304
    s_mov_b32 s47, 256
    buffer_load_dwordx4 v1, s[24:27], 0 offen offset:0 nt lds
    buffer_load_dwordx4 v2, s[24:27], 0 offen offset:1024 nt lds
    buffer_load_dwordx4 v3, s[24:27], 0 offen offset:2048 nt lds
    buffer_load_dwordx4 v4, s[24:27], 0 offen offset:3072 nt lds
    s_mov_b32 m0, 102400
    s_nop 0
    buffer_load_dwordx4 v1, s[24:27], s47 offen offset:0 nt lds
    buffer_load_dwordx4 v2, s[24:27], s47 offen offset:1024 nt lds
    buffer_load_dwordx4 v3, s[24:27], s47 offen offset:2048 nt lds
    buffer_load_dwordx4 v4, s[24:27], s47 offen offset:3072 nt lds
    s_mov_b32 m0, 4096
    s_xor_b32 s47, s42, 256
    buffer_load_dwordx4 v1, s[16:19], s47 offen offset:0 nt lds
    buffer_load_dwordx4 v2, s[16:19], s47 offen offset:1024 nt lds
    buffer_load_dwordx4 v3, s[16:19], s47 offen offset:2048 nt lds
    buffer_load_dwordx4 v4, s[16:19], s47 offen offset:3072 nt lds
    s_mov_b32 m0, 8192
    s_xor_b32 s47, s42, 8192
    buffer_load_dwordx4 v1, s[16:19], s47 offen offset:0 nt lds
    buffer_load_dwordx4 v2, s[16:19], s47 offen offset:1024 nt lds
    buffer_load_dwordx4 v3, s[16:19], s47 offen offset:2048 nt lds
    buffer_load_dwordx4 v4, s[16:19], s47 offen offset:3072 nt lds
    s_mov_b32 m0, 12288
    s_xor_b32 s47, s42, 8448
    buffer_load_dwordx4 v1, s[16:19], s47 offen offset:0 nt lds
    buffer_load_dwordx4 v2, s[16:19], s47 offen offset:1024 nt lds
    buffer_load_dwordx4 v3, s[16:19], s47 offen offset:2048 nt lds
    buffer_load_dwordx4 v4, s[16:19], s47 offen offset:3072 nt lds
    s_mov_b32 m0, 16384
    s_xor_b32 s47, s42, 16384
    buffer_load_dwordx4 v1, s[16:19], s47 offen offset:0 nt lds
    buffer_load_dwordx4 v2, s[16:19], s47 offen offset:1024 nt lds
    buffer_load_dwordx4 v3, s[16:19], s47 offen offset:2048 nt lds
    buffer_load_dwordx4 v4, s[16:19], s47 offen offset:3072 nt lds
    s_mov_b32 m0, 20480
    s_xor_b32 s47, s42, 16640
    buffer_load_dwordx4 v1, s[16:19], s47 offen offset:0 nt lds
    buffer_load_dwordx4 v2, s[16:19], s47 offen offset:1024 nt lds
    buffer_load_dwordx4 v3, s[16:19], s47 offen offset:2048 nt lds
    buffer_load_dwordx4 v4, s[16:19], s47 offen offset:3072 nt lds
    s_add_u32 s20, s8, s62
    s_addc_u32 s21, s9, 0
    s_mov_b32 s22, 0x100000
    s_mov_b32 s23, 0x20000
    v_mov_b32 v22, 0
    ds_write2_b32 v32, v22, v22 offset0:0 offset1:1
    s_mov_b32 s58, 24576
    s_mov_b32 s57, 6
    s_mov_b32 s43, 24576
    s_waitcnt lgkmcnt(0)
    s_barrier
    ds_read_b128 v[36:39], v32 offset:16
    v_mov_b32 v40, 0
    s_waitcnt lgkmcnt(0)
    s_mov_b32 s41, 128
L_lklo:
    s_xor_b32 s47, s43, s42
    s_waitcnt lgkmcnt(1)
L_chk0:
    v_min3_u32 v22, v36, v37, v38
    v_min_u32 v22, v22, v39
    v_cmp_ne_u32 vcc, 0, v40
    ds_read_b128 v[36:39], v32 offset:16
    ds_read_b32 v40, v32 offset:4
    v_readfirstlane_b32 s59, v22
    s_mov_b32 m0, s58
    s_add_i32 s56, s57, -2
    v_mov_b32 v23, s56
    s_add_u32 s59, s59, 24
    s_cmp_ge_u32 s57, s59
    s_cbranch_scc1 L_spin0
    s_waitcnt vmcnt(18)
    buffer_load_dwordx4 v1, s[16:19], s47 offen offset:0 nt lds
    s_add_u32 s58, s58, 4096
    s_cmp_ge_u32 s58, 98304
    s_cselect_b32 s58, 0, s58
    s_waitcnt vmcnt(18)
    buffer_load_dwordx4 v2, s[16:19], s47 offen offset:1024 nt lds
    s_add_u32 s57, s57, 1
    s_waitcnt vmcnt(18)
    buffer_load_dwordx4 v3, s[16:19], s47 offen offset:2048 nt lds
    ds_write_b32 v32, v23
    s_or_b32 s43, s43, 65536
    s_add_u32 s43, s43, 8192
    s_andn2_b32 s43, s43, 65536
    s_waitcnt vmcnt(18)
    buffer_load_dwordx4 v4, s[16:19], s47 offen offset:3072 nt lds
    s_xor_b32 s47, s47, 256
    s_waitcnt lgkmcnt(1)
L_chk1:
    v_min3_u32 v22, v36, v37, v38
    v_min_u32 v22, v22, v39
    v_cmp_ne_u32 vcc, 0, v40
    ds_read_b128 v[36:39], v32 offset:16
    ds_read_b32 v40, v32 offset:4
    v_readfirstlane_b32 s59, v22
    s_mov_b32 m0, s58
    s_add_i32 s56, s57, -2
    v_mov_b32 v23, s56
    s_add_u32 s59, s59, 24
    s_cmp_ge_u32 s57, s59
    s_cbranch_scc1 L_spin1
    s_waitcnt vmcnt(18)
    buffer_load_dwordx4 v1, s[16:19], s47 offen offset:0 nt lds
    s_add_u32 s58, s58, 4096
    s_cmp_ge_u32 s58, 98304
    s_cselect_b32 s58, 0, s58
    s_waitcnt vmcnt(18)
    buffer_load_dwordx4 v2, s[16:19], s47 offen offset:1024 nt lds
    s_add_u32 s57, s57, 1
    s_waitcnt vmcnt(18)
    buffer_load_dwordx4 v3, s[16:19], s47 offen offset:2048 nt lds
    ds_write_b32 v32, v23
    s_waitcnt vmcnt(18)
    buffer_load_dwordx4 v4, s[16:19], s47 offen offset:3072 nt lds
    s_cmp_ge_u32 s57, s41
    s_cbranch_scc1 L_lkdone
    s_cbranch_vccnz L_lkhi
    s_branch L_lklo
L_lkhi:
    s_xor_b32 s47, s43, s42
    s_waitcnt lgkmcnt(1)
L_chk2:
    v_min3_u32 v22, v36, v37, v38
    v_min_u32 v22, v22, v39
    v_cmp_ne_u32 vcc, 0, v40
    ds_read_b128 v[36:39], v32 offset:16
    ds_read_b32 v40, v32 offset:4
    v_readfirstlane_b32 s59, v22
    s_mov_b32 m0, s58
    s_add_i32 s56, s57, -3
    v_mov_b32 v23, s56
    s_add_u32 s59, s59, 24
    s_cmp_ge_u32 s57, s59
    s_cbranch_scc1 L_spin2
    s_waitcnt vmcnt(21)
    buffer_load_dwordx4 v1, s[16:19], s47 offen offset:0 nt lds
    s_add_u32 s58, s58, 4096
    s_cmp_ge_u32 s58, 98304
    s_cselect_b32 s58, 0, s58
    s_waitcnt vmcnt(21)
    buffer_load_dwordx4 v2, s[16:19], s47 offen offset:1024 nt lds
    ds_write_b32 v32, v23
    s_add_u32 s57, s57, 1
    s_waitcnt vmcnt(21)
    buffer_load_dwordx4 v3, s[16:19], s47 offen offset:2048 nt lds
    s_or_b32 s43, s43, 65536
    s_add_u32 s43, s43, 8192
    s_andn2_b32 s43, s43, 65536
    s_waitcnt vmcnt(21)
    buffer_load_dwordx4 v4, s[16:19], s47 offen offset:3072 nt lds
    s_xor_b32 s47, s47, 256
    s_waitcnt lgkmcnt(1)
L_chk3:
    v_min3_u32 v22, v36, v37, v38
    v_min_u32 v22, v22, v39
    v_cmp_ne_u32 vcc, 0, v40
    ds_read_b128 v[36:39], v32 offset:16
    ds_read_b32 v40, v32 offset:4
    v_readfirstlane_b32 s59, v22
    s_mov_b32 m0, s58
    s_add_i32 s56, s57, -3
    v_mov_b32 v23, s56
    s_add_u32 s59, s59, 24
    s_cmp_ge_u32 s57, s59
    s_cbranch_scc1 L_spin3
    s_waitcnt vmcnt(21)
    buffer_load_dwordx4 v1, s[16:19], s47 offen offset:0 nt lds
    s_add_u32 s58, s58, 4096
    s_cmp_ge_u32 s58, 98304
    s_cselect_b32 s58, 0, s58
    s_waitcnt vmcnt(21)
    buffer_load_dwordx4 v2, s[16:19], s47 offen offset:1024 nt lds
    ds_write_b32 v32, v23
    s_add_u32 s57, s57, 1
    s_waitcnt vmcnt(21)
    buffer_load_dwordx4 v3, s[16:19], s47 offen offset:2048 nt lds
    s_waitcnt vmcnt(21)
    buffer_load_dwordx4 v4, s[16:19], s47 offen offset:3072 nt lds
    s_cmp_ge_u32 s57, s41
    s_cbranch_scc1 L_lkdone
    s_cbranch_vccz L_lklo
    s_branch L_lkhi
L_lkdone:
    s_mov_b32 s43, s48
    s_cbranch_vccnz L_lvhi
L_lvlo:
    s_xor_b32 s47, s43, s42
    s_waitcnt lgkmcnt(1)
L_chk4:
    v_min3_u32 v22, v36, v37, v38
    v_min_u32 v22, v22, v39
    v_cmp_ne_u32 vcc, 0, v40
    ds_read_b128 v[36:39], v32 offset:16
    ds_read_b32 v40, v32 offset:4
    v_readfirstlane_b32 s59, v22
    s_mov_b32 m0, s58
    s_add_i32 s56, s57, -2
    v_mov_b32 v23, s56
    s_add_u32 s59, s59, 24
    s_cmp_ge_u32 s57, s59
    s_cbranch_scc1 L_spin4
    s_waitcnt vmcnt(18)
    buffer_load_dwordx4 v1, s[20:23], s47 offen offset:0 nt lds
    s_add_u32 s58, s58, 4096
    s_cmp_ge_u32 s58, 98304
    s_cselect_b32 s58, 0, s58
    s_waitcnt vmcnt(18)
    buffer_load_dwordx4 v2, s[20:23], s47 offen offset:1024 nt lds
    s_add_u32 s57, s57, 1
    s_waitcnt vmcnt(18)
    buffer_load_dwordx4 v3, s[20:23], s47 offen offset:2048 nt lds
    ds_write_b32 v32, v23
    s_or_b32 s43, s43, 65536
    s_add_u32 s43, s43, 8192
    s_andn2_b32 s43, s43, 65536
    s_cmp_eq_u32 s57, 192
    s_cselect_b32 s43, s49, s43
    s_waitcnt vmcnt(18)
    buffer_load_dwordx4 v4, s[20:23], s47 offen offset:3072 nt lds
    s_cmp_ge_u32 s57, 256
    s_cbranch_scc1 L_lvdone
    s_cbranch_vccnz L_lvhi
    s_branch L_lvlo
L_lvhi:
    s_xor_b32 s47, s43, s42
    s_waitcnt lgkmcnt(1)
L_chk5:
    v_min3_u32 v22, v36, v37, v38
    v_min_u32 v22, v22, v39
    v_cmp_ne_u32 vcc, 0, v40
    ds_read_b128 v[36:39], v32 offset:16
    ds_read_b32 v40, v32 offset:4
    v_readfirstlane_b32 s59, v22
    s_mov_b32 m0, s58
    s_add_i32 s56, s57, -3
    v_mov_b32 v23, s56
    s_add_u32 s59, s59, 24
    s_cmp_ge_u32 s57, s59
    s_cbranch_scc1 L_spin5
    s_waitcnt vmcnt(21)
    buffer_load_dwordx4 v1, s[20:23], s47 offen offset:0 nt lds
    s_add_u32 s58, s58, 4096
    s_cmp_ge_u32 s58, 98304
    s_cselect_b32 s58, 0, s58
    s_waitcnt vmcnt(21)
    buffer_load_dwordx4 v2, s[20:23], s47 offen offset:1024 nt lds
    ds_write_b32 v32, v23
    s_add_u32 s57, s57, 1
    s_waitcnt vmcnt(21)
    buffer_load_dwordx4 v3, s[20:23], s47 offen offset:2048 nt lds
    s_or_b32 s43, s43, 65536
    s_add_u32 s43, s43, 8192
    s_andn2_b32 s43, s43, 65536
    s_cmp_eq_u32 s57, 192
    s_cselect_b32 s43, s49, s43
    s_waitcnt vmcnt(21)
    buffer_load_dwordx4 v4, s[20:23], s47 offen offset:3072 nt lds
    s_cmp_ge_u32 s57, 256
    s_cbranch_scc1 L_lvdone
    s_cbranch_vccz L_lvlo
    s_branch L_lvhi
L_lvdone:
    v_mov_b32 v23, 253
    s_waitcnt vmcnt(20)
    ds_write_b32 v32, v23
    v_mov_b32 v23, 254
    s_waitcnt vmcnt(16)
    ds_write_b32 v32, v23
    v_mov_b32 v23, 255
    s_waitcnt vmcnt(12)
    ds_write_b32 v32, v23
    v_mov_b32 v23, 256
    s_waitcnt vmcnt(8)
    ds_write_b32 v32, v23
    v_mov_b32 v23, 257
    s_waitcnt vmcnt(4)
    ds_write_b32 v32, v23
    v_mov_b32 v23, 258
    s_waitcnt vmcnt(0)
    ds_write_b32 v32, v23
    s_endpgm
L_spin0:
    s_waitcnt lgkmcnt(0)
    s_branch L_chk0
L_spin1:
    s_waitcnt lgkmcnt(0)
    s_branch L_chk1
L_spin2:
    s_waitcnt lgkmcnt(0)
    s_branch L_chk2
L_spin3:
    s_waitcnt lgkmcnt(0)
    s_branch L_chk3
L_spin4:
    s_waitcnt lgkmcnt(0)
    s_branch L_chk4
L_spin5:
    s_waitcnt lgkmcnt(0)
    s_branch L_chk5
L_consumer:
    v_mov_b32 v32, 131584
    s_lshl_b32 s63, s63, 13
    s_lshl_b32 s49, s49, 8
    s_xor_b32 s48, s49, 0x100
    s_cmp_eq_u32 s44, 5
    s_cbranch_scc1 L_ctrl
    s_sub_u32 s46, s44, 1
    v_add_u32 v31, -1, v31
    s_add_u32 s28, s10, s63
    s_addc_u32 s29, s11, 0
    s_mov_b32 s30, 0x2000
    s_mov_b32 s31, 0x20000
    s_mov_b32 s36, s14
    s_mov_b32 s37, s15
    s_mov_b32 s38, 0x140000
    s_mov_b32 s39, 0x20000
    s_lshr_b32 s32, s62, 10
    s_lshl1_add_u32 s32, s49, s32
    s_xor_b32 s33, s32, 512
    s_lshr_b32 s34, s32, 2
    s_add_u32 s34, s34, 0x20000
    s_xor_b32 s35, s34, 128
    s_getreg_b32 s42, hwreg(HW_REG_XCC_ID)
    s_and_b32 s42, s42, 15
    s_mov_b32 s43, 0
    s_mov_b32 s55, 0
    s_mov_b32 s45, 0x3db8aa3b
    v_lshlrev_b32 v24, 5, v31
    buffer_load_dword v27, v24, s[36:39], s34 offen sc1
    buffer_load_dword v28, v24, s[36:39], s35 offen sc1
    v_lshl_add_u32 v4, v18, 3, v24
    v_lshlrev_b32 v1, 3, v18
    v_lshl_add_u32 v1, v31, 7, v1
    s_add_u32 s20, s8, s62
    s_addc_u32 s21, s9, 0
    s_mov_b32 s22, 0x100000
    s_mov_b32 s23, 0x20000
    buffer_load_dword v96, v24, s[20:23], 0 offen nt
    v_lshlrev_b32 v26, 4, v0
    v_add_u32 v26, 261120, v26
    v_lshlrev_b32 v17, 9, v18
    v_lshl_add_u32 v17, v19, 4, v17
    v_lshl_add_u32 v17, v31, 6, v17
    v_and_b32 v22, 12, v18
    v_mov_b32 v23, 0x1320
    v_bfe_u32 v22, v23, v22, 2
    v_and_b32 v24, 3, v18
    v_lshl_add_u32 v22, v24, 2, v22
    v_xor_b32 v22, v22, v19
    v_lshlrev_b32 v24, 8, v18
    v_lshl_add_u32 v5, v22, 4, v24
    v_xor_b32 v34, 4, v22
    v_lshl_add_u32 v6, v34, 4, v24
    v_xor_b32 v34, 8, v22
    v_lshl_add_u32 v7, v34, 4, v24
    v_xor_b32 v34, 12, v22
    v_lshl_add_u32 v8, v34, 4, v24
    v_add_u32 v9, 0x10000, v5
    v_add_u32 v10, 0x10000, v6
    v_add_u32 v11, 0x10000, v7
    v_add_u32 v12, 0x10000, v8
    v_lshlrev_b32 v22, 2, v19
    v_bfe_u32 v24, v23, v22, 2
    v_and_b32 v34, 12, v18
    v_add_u32 v24, v24, v34
    v_and_b32 v34, 3, v18
    v_lshl_add_u32 v34, v31, 2, v34
    v_xor_b32 v24, v24, v34
    v_lshrrev_b32 v34, 2, v18
    v_add_u32 v22, v22, v34
    v_lshlrev_b32 v22, 8, v22
    v_lshl_add_u32 v13, v24, 4, v22
    v_and_b32 v22, 63, v0
    v_lshlrev_b32 v22, 4, v22
    v_add_u32 v15, 98304, v22
    s_mov_b32 s56, 0
    s_cmp_ge_i32 s56, 3
    s_cbranch_scc1 L_pd0
L_pl0:
    ds_read_b32 v34, v32 offset:0
    s_waitcnt lgkmcnt(0)
    v_readfirstlane_b32 s56, v34
    s_cmp_ge_i32 s56, 3
    s_cbranch_scc1 L_pd0
    s_sleep 1
    s_branch L_pl0
L_pd0:
    ds_read_b128 v[100:103], v9 offset:32768
    ds_read_b128 v[104:107], v10 offset:32768
    ds_read_b128 v[108:111], v11 offset:32768
    ds_read_b128 v[112:115], v12 offset:32768
    ds_read_b128 v[116:119], v9 offset:36864
    ds_read_b128 v[120:123], v10 offset:36864
    ds_read_b128 v[124:127], v11 offset:36864
    ds_read_b128 v[128:131], v12 offset:36864
    s_lshl_b32 s52, s46, 13
    s_waitcnt lgkmcnt(0)
    v_add_u32 v5, s52, v5
    v_add_u32 v6, s52, v6
    v_add_u32 v7, s52, v7
    v_add_u32 v8, s52, v8
    v_add_u32 v9, s52, v9
    v_add_u32 v10, s52, v10
    v_add_u32 v11, s52, v11
    v_add_u32 v12, s52, v12
    s_lshl_b32 s53, s46, 1
    s_add_u32 s53, s53, 4
    s_add_u32 s54, s53, 4
    s_cmp_ge_i32 s56, s53
    s_cbranch_scc1 L_pd1
L_pl1:
    ds_read_b32 v34, v32 offset:0
    s_waitcnt lgkmcnt(0)
    v_readfirstlane_b32 s56, v34
    s_cmp_ge_i32 s56, s53
    s_cbranch_scc1 L_pd1
    s_sleep 1
    s_branch L_pl1
L_pd1:
    ds_read_b128 v[36:39], v5 offset:0
    ds_read_b128 v[40:43], v6 offset:0
    ds_read_b128 v[44:47], v7 offset:0
    ds_read_b128 v[48:51], v8 offset:0
    ds_read_b128 v[52:55], v5 offset:4096
    ds_read_b128 v[56:59], v6 offset:4096
    ds_read_b128 v[60:63], v7 offset:4096
    ds_read_b128 v[64:67], v8 offset:4096
    v_mov_b32 v22, s54
    s_add_u32 s53, s53, 8
    s_add_u32 s54, s54, 8
    s_waitcnt lgkmcnt(7)
    v_mfma_f32_16x16x32_bf16 v[132:135], v[36:39], v[100:103], 0
    s_waitcnt lgkmcnt(6)
    v_mfma_f32_16x16x32_bf16 v[132:135], v[40:43], v[104:107], v[132:135]
    s_waitcnt lgkmcnt(5)
    v_mfma_f32_16x16x32_bf16 v[132:135], v[44:47], v[108:111], v[132:135]
    s_waitcnt lgkmcnt(4)
    v_mfma_f32_16x16x32_bf16 v[132:135], v[48:51], v[112:115], v[132:135]
    s_waitcnt lgkmcnt(3)
    v_mfma_f32_16x16x32_bf16 v[132:135], v[52:55], v[116:119], v[132:135]
    s_waitcnt lgkmcnt(2)
    v_mfma_f32_16x16x32_bf16 v[132:135], v[56:59], v[120:123], v[132:135]
    s_waitcnt lgkmcnt(1)
    v_mfma_f32_16x16x32_bf16 v[132:135], v[60:63], v[124:127], v[132:135]
    s_waitcnt lgkmcnt(0)
    v_mfma_f32_16x16x32_bf16 v[132:135], v[64:67], v[128:131], v[132:135]
    ds_write_b32 v33, v22 offset:16
    s_cmp_ge_i32 s56, s53
    s_cbranch_scc1 L_pd2
L_pl2:
    ds_read_b32 v34, v32 offset:0
    s_waitcnt lgkmcnt(0)
    v_readfirstlane_b32 s56, v34
    s_cmp_ge_i32 s56, s53
    s_cbranch_scc1 L_pd2
    s_sleep 1
    s_branch L_pl2
L_pd2:
    ds_read_b128 v[36:39], v5 offset:32768
    ds_read_b128 v[40:43], v6 offset:32768
    ds_read_b128 v[44:47], v7 offset:32768
    ds_read_b128 v[48:51], v8 offset:32768
    ds_read_b128 v[52:55], v5 offset:36864
    ds_read_b128 v[56:59], v6 offset:36864
    ds_read_b128 v[60:63], v7 offset:36864
    ds_read_b128 v[64:67], v8 offset:36864
    v_mov_b32 v22, s54
    s_add_u32 s53, s53, 8
    s_add_u32 s54, s54, 8
    s_waitcnt lgkmcnt(7)
    v_mfma_f32_16x16x32_bf16 v[136:139], v[36:39], v[100:103], 0
    s_waitcnt lgkmcnt(6)
    v_mfma_f32_16x16x32_bf16 v[136:139], v[40:43], v[104:107], v[136:139]
    s_waitcnt lgkmcnt(5)
    v_mfma_f32_16x16x32_bf16 v[136:139], v[44:47], v[108:111], v[136:139]
    s_waitcnt lgkmcnt(4)
    v_mfma_f32_16x16x32_bf16 v[136:139], v[48:51], v[112:115], v[136:139]
    s_waitcnt lgkmcnt(3)
    v_mfma_f32_16x16x32_bf16 v[136:139], v[52:55], v[116:119], v[136:139]
    s_waitcnt lgkmcnt(2)
    v_mfma_f32_16x16x32_bf16 v[136:139], v[56:59], v[120:123], v[136:139]
    s_waitcnt lgkmcnt(1)
    v_mfma_f32_16x16x32_bf16 v[136:139], v[60:63], v[124:127], v[136:139]
    s_waitcnt lgkmcnt(0)
    v_mfma_f32_16x16x32_bf16 v[136:139], v[64:67], v[128:131], v[136:139]
    ds_write_b32 v33, v22 offset:16
    s_cmp_ge_i32 s56, s53
    s_cbranch_scc1 L_pd3
L_pl3:
    ds_read_b32 v34, v32 offset:0
    s_waitcnt lgkmcnt(0)
    v_readfirstlane_b32 s56, v34
    s_cmp_ge_i32 s56, s53
    s_cbranch_scc1 L_pd3
    s_sleep 1
    s_branch L_pl3
L_pd3:
    ds_read_b128 v[36:39], v9 offset:0
    ds_read_b128 v[40:43], v10 offset:0
    ds_read_b128 v[44:47], v11 offset:0
    ds_read_b128 v[48:51], v12 offset:0
    ds_read_b128 v[52:55], v9 offset:4096
    ds_read_b128 v[56:59], v10 offset:4096
    ds_read_b128 v[60:63], v11 offset:4096
    ds_read_b128 v[64:67], v12 offset:4096
    v_mov_b32 v22, s54
    s_add_u32 s53, s53, 8
    s_add_u32 s54, s54, 8
    s_waitcnt lgkmcnt(7)
    v_mfma_f32_16x16x32_bf16 v[140:143], v[36:39], v[100:103], 0
    s_waitcnt lgkmcnt(6)
    v_mfma_f32_16x16x32_bf16 v[140:143], v[40:43], v[104:107], v[140:143]
    s_waitcnt lgkmcnt(5)
    v_mfma_f32_16x16x32_bf16 v[140:143], v[44:47], v[108:111], v[140:143]
    s_waitcnt lgkmcnt(4)
    v_mfma_f32_16x16x32_bf16 v[140:143], v[48:51], v[112:115], v[140:143]
    s_waitcnt lgkmcnt(3)
    v_mfma_f32_16x16x32_bf16 v[140:143], v[52:55], v[116:119], v[140:143]
    s_waitcnt lgkmcnt(2)
    v_mfma_f32_16x16x32_bf16 v[140:143], v[56:59], v[120:123], v[140:143]
    s_waitcnt lgkmcnt(1)
    v_mfma_f32_16x16x32_bf16 v[140:143], v[60:63], v[124:127], v[140:143]
    s_waitcnt lgkmcnt(0)
    v_mfma_f32_16x16x32_bf16 v[140:143], v[64:67], v[128:131], v[140:143]
    ds_write_b32 v33, v22 offset:16
    s_cmp_ge_i32 s56, s53
    s_cbranch_scc1 L_pd4
L_pl4:
    ds_read_b32 v34, v32 offset:0
    s_waitcnt lgkmcnt(0)
    v_readfirstlane_b32 s56, v34
    s_cmp_ge_i32 s56, s53
    s_cbranch_scc1 L_pd4
    s_sleep 1
    s_branch L_pl4
L_pd4:
    ds_read_b128 v[36:39], v5 offset:0
    ds_read_b128 v[40:43], v6 offset:0
    ds_read_b128 v[44:47], v7 offset:0
    ds_read_b128 v[48:51], v8 offset:0
    ds_read_b128 v[52:55], v5 offset:4096
    ds_read_b128 v[56:59], v6 offset:4096
    ds_read_b128 v[60:63], v7 offset:4096
    ds_read_b128 v[64:67], v8 offset:4096
    v_mov_b32 v22, s54
    s_add_u32 s53, s53, 8
    s_add_u32 s54, s54, 8
    s_waitcnt lgkmcnt(7)
    v_mfma_f32_16x16x32_bf16 v[144:147], v[36:39], v[100:103], 0
    s_waitcnt lgkmcnt(6)
    v_mfma_f32_16x16x32_bf16 v[144:147], v[40:43], v[104:107], v[144:147]
    s_waitcnt lgkmcnt(5)
    v_mfma_f32_16x16x32_bf16 v[144:147], v[44:47], v[108:111], v[144:147]
    s_waitcnt lgkmcnt(4)
    v_mfma_f32_16x16x32_bf16 v[144:147], v[48:51], v[112:115], v[144:147]
    s_waitcnt lgkmcnt(3)
    v_mfma_f32_16x16x32_bf16 v[144:147], v[52:55], v[116:119], v[144:147]
    s_waitcnt lgkmcnt(2)
    v_mfma_f32_16x16x32_bf16 v[144:147], v[56:59], v[120:123], v[144:147]
    s_waitcnt lgkmcnt(1)
    v_mfma_f32_16x16x32_bf16 v[144:147], v[60:63], v[124:127], v[144:147]
    s_waitcnt lgkmcnt(0)
    v_mfma_f32_16x16x32_bf16 v[144:147], v[64:67], v[128:131], v[144:147]
    ds_write_b32 v33, v22 offset:16
    s_cmp_ge_i32 s56, s53
    s_cbranch_scc1 L_pd5
L_pl5:
    ds_read_b32 v34, v32 offset:0
    s_waitcnt lgkmcnt(0)
    v_readfirstlane_b32 s56, v34
    s_cmp_ge_i32 s56, s53
    s_cbranch_scc1 L_pd5
    s_sleep 1
    s_branch L_pl5
L_pd5:
    ds_read_b128 v[36:39], v5 offset:32768
    ds_read_b128 v[40:43], v6 offset:32768
    ds_read_b128 v[44:47], v7 offset:32768
    ds_read_b128 v[48:51], v8 offset:32768
    ds_read_b128 v[52:55], v5 offset:36864
    ds_read_b128 v[56:59], v6 offset:36864
    ds_read_b128 v[60:63], v7 offset:36864
    ds_read_b128 v[64:67], v8 offset:36864
    v_mov_b32 v22, s54
    s_add_u32 s53, s53, 8
    s_add_u32 s54, s54, 8
    s_waitcnt lgkmcnt(7)
    v_mfma_f32_16x16x32_bf16 v[148:151], v[36:39], v[100:103], 0
    s_waitcnt lgkmcnt(6)
    v_mfma_f32_16x16x32_bf16 v[148:151], v[40:43], v[104:107], v[148:151]
    s_waitcnt lgkmcnt(5)
    v_mfma_f32_16x16x32_bf16 v[148:151], v[44:47], v[108:111], v[148:151]
    s_waitcnt lgkmcnt(4)
    v_mfma_f32_16x16x32_bf16 v[148:151], v[48:51], v[112:115], v[148:151]
    s_waitcnt lgkmcnt(3)
    v_mfma_f32_16x16x32_bf16 v[148:151], v[52:55], v[116:119], v[148:151]
    s_waitcnt lgkmcnt(2)
    v_mfma_f32_16x16x32_bf16 v[148:151], v[56:59], v[120:123], v[148:151]
    s_waitcnt lgkmcnt(1)
    v_mfma_f32_16x16x32_bf16 v[148:151], v[60:63], v[124:127], v[148:151]
    s_waitcnt lgkmcnt(0)
    v_mfma_f32_16x16x32_bf16 v[148:151], v[64:67], v[128:131], v[148:151]
    ds_write_b32 v33, v22 offset:16
    s_cmp_ge_i32 s56, s53
    s_cbranch_scc1 L_pd6
L_pl6:
    ds_read_b32 v34, v32 offset:0
    s_waitcnt lgkmcnt(0)
    v_readfirstlane_b32 s56, v34
    s_cmp_ge_i32 s56, s53
    s_cbranch_scc1 L_pd6
    s_sleep 1
    s_branch L_pl6
L_pd6:
    ds_read_b128 v[36:39], v9 offset:0
    ds_read_b128 v[40:43], v10 offset:0
    ds_read_b128 v[44:47], v11 offset:0
    ds_read_b128 v[48:51], v12 offset:0
    ds_read_b128 v[52:55], v9 offset:4096
    ds_read_b128 v[56:59], v10 offset:4096
    ds_read_b128 v[60:63], v11 offset:4096
    ds_read_b128 v[64:67], v12 offset:4096
    v_mov_b32 v22, s54
    s_add_u32 s53, s53, 8
    s_add_u32 s54, s54, 8
    s_waitcnt lgkmcnt(7)
    v_mfma_f32_16x16x32_bf16 v[152:155], v[36:39], v[100:103], 0
    s_waitcnt lgkmcnt(6)
    v_mfma_f32_16x16x32_bf16 v[152:155], v[40:43], v[104:107], v[152:155]
    s_waitcnt lgkmcnt(5)
    v_mfma_f32_16x16x32_bf16 v[152:155], v[44:47], v[108:111], v[152:155]
    s_waitcnt lgkmcnt(4)
    v_mfma_f32_16x16x32_bf16 v[152:155], v[48:51], v[112:115], v[152:155]
    s_waitcnt lgkmcnt(3)
    v_mfma_f32_16x16x32_bf16 v[152:155], v[52:55], v[116:119], v[152:155]
    s_waitcnt lgkmcnt(2)
    v_mfma_f32_16x16x32_bf16 v[152:155], v[56:59], v[120:123], v[152:155]
    s_waitcnt lgkmcnt(1)
    v_mfma_f32_16x16x32_bf16 v[152:155], v[60:63], v[124:127], v[152:155]
    s_waitcnt lgkmcnt(0)
    v_mfma_f32_16x16x32_bf16 v[152:155], v[64:67], v[128:131], v[152:155]
    ds_write_b32 v33, v22 offset:16
    s_cmp_ge_i32 s56, s53
    s_cbranch_scc1 L_pd7
L_pl7:
    ds_read_b32 v34, v32 offset:0
    s_waitcnt lgkmcnt(0)
    v_readfirstlane_b32 s56, v34
    s_cmp_ge_i32 s56, s53
    s_cbranch_scc1 L_pd7
    s_sleep 1
    s_branch L_pl7
L_pd7:
    ds_read_b128 v[36:39], v5 offset:0
    ds_read_b128 v[40:43], v6 offset:0
    ds_read_b128 v[44:47], v7 offset:0
    ds_read_b128 v[48:51], v8 offset:0
    ds_read_b128 v[52:55], v5 offset:4096
    ds_read_b128 v[56:59], v6 offset:4096
    ds_read_b128 v[60:63], v7 offset:4096
    ds_read_b128 v[64:67], v8 offset:4096
    v_mov_b32 v22, s54
    s_add_u32 s53, s53, 8
    s_add_u32 s54, s54, 8
    s_waitcnt lgkmcnt(7)
    v_mfma_f32_16x16x32_bf16 v[156:159], v[36:39], v[100:103], 0
    s_waitcnt lgkmcnt(6)
    v_mfma_f32_16x16x32_bf16 v[156:159], v[40:43], v[104:107], v[156:159]
    s_waitcnt lgkmcnt(5)
    v_mfma_f32_16x16x32_bf16 v[156:159], v[44:47], v[108:111], v[156:159]
    s_waitcnt lgkmcnt(4)
    v_mfma_f32_16x16x32_bf16 v[156:159], v[48:51], v[112:115], v[156:159]
    s_waitcnt lgkmcnt(3)
    v_mfma_f32_16x16x32_bf16 v[156:159], v[52:55], v[116:119], v[156:159]
    s_waitcnt lgkmcnt(2)
    v_mfma_f32_16x16x32_bf16 v[156:159], v[56:59], v[120:123], v[156:159]
    s_waitcnt lgkmcnt(1)
    v_mfma_f32_16x16x32_bf16 v[156:159], v[60:63], v[124:127], v[156:159]
    s_waitcnt lgkmcnt(0)
    v_mfma_f32_16x16x32_bf16 v[156:159], v[64:67], v[128:131], v[156:159]
    ds_write_b32 v33, v22 offset:16
    s_cmp_ge_i32 s56, s53
    s_cbranch_scc1 L_pd8
L_pl8:
    ds_read_b32 v34, v32 offset:0
    s_waitcnt lgkmcnt(0)
    v_readfirstlane_b32 s56, v34
    s_cmp_ge_i32 s56, s53
    s_cbranch_scc1 L_pd8
    s_sleep 1
    s_branch L_pl8
L_pd8:
    ds_read_b128 v[36:39], v5 offset:32768
    ds_read_b128 v[40:43], v6 offset:32768
    ds_read_b128 v[44:47], v7 offset:32768
    ds_read_b128 v[48:51], v8 offset:32768
    ds_read_b128 v[52:55], v5 offset:36864
    ds_read_b128 v[56:59], v6 offset:36864
    ds_read_b128 v[60:63], v7 offset:36864
    ds_read_b128 v[64:67], v8 offset:36864
    v_mov_b32 v22, s54
    s_add_u32 s53, s53, 8
    s_add_u32 s54, s54, 8
    s_waitcnt lgkmcnt(7)
    v_mfma_f32_16x16x32_bf16 v[160:163], v[36:39], v[100:103], 0
    s_waitcnt lgkmcnt(6)
    v_mfma_f32_16x16x32_bf16 v[160:163], v[40:43], v[104:107], v[160:163]
    s_waitcnt lgkmcnt(5)
    v_mfma_f32_16x16x32_bf16 v[160:163], v[44:47], v[108:111], v[160:163]
    s_waitcnt lgkmcnt(4)
    v_mfma_f32_16x16x32_bf16 v[160:163], v[48:51], v[112:115], v[160:163]
    s_waitcnt lgkmcnt(3)
    v_mfma_f32_16x16x32_bf16 v[160:163], v[52:55], v[116:119], v[160:163]
    s_waitcnt lgkmcnt(2)
    v_mfma_f32_16x16x32_bf16 v[160:163], v[56:59], v[120:123], v[160:163]
    s_waitcnt lgkmcnt(1)
    v_mfma_f32_16x16x32_bf16 v[160:163], v[60:63], v[124:127], v[160:163]
    s_waitcnt lgkmcnt(0)
    v_mfma_f32_16x16x32_bf16 v[160:163], v[64:67], v[128:131], v[160:163]
    ds_write_b32 v33, v22 offset:16
    s_cmp_ge_i32 s56, s53
    s_cbranch_scc1 L_pd9
L_pl9:
    ds_read_b32 v34, v32 offset:0
    s_waitcnt lgkmcnt(0)
    v_readfirstlane_b32 s56, v34
    s_cmp_ge_i32 s56, s53
    s_cbranch_scc1 L_pd9
    s_sleep 1
    s_branch L_pl9
L_pd9:
    ds_read_b128 v[36:39], v9 offset:0
    ds_read_b128 v[40:43], v10 offset:0
    ds_read_b128 v[44:47], v11 offset:0
    ds_read_b128 v[48:51], v12 offset:0
    ds_read_b128 v[52:55], v9 offset:4096
    ds_read_b128 v[56:59], v10 offset:4096
    ds_read_b128 v[60:63], v11 offset:4096
    ds_read_b128 v[64:67], v12 offset:4096
    v_mov_b32 v22, s54
    s_add_u32 s53, s53, 8
    s_add_u32 s54, s54, 8
    s_waitcnt lgkmcnt(7)
    v_mfma_f32_16x16x32_bf16 v[164:167], v[36:39], v[100:103], 0
    s_waitcnt lgkmcnt(6)
    v_mfma_f32_16x16x32_bf16 v[164:167], v[40:43], v[104:107], v[164:167]
    s_waitcnt lgkmcnt(5)
    v_mfma_f32_16x16x32_bf16 v[164:167], v[44:47], v[108:111], v[164:167]
    s_waitcnt lgkmcnt(4)
    v_mfma_f32_16x16x32_bf16 v[164:167], v[48:51], v[112:115], v[164:167]
    s_waitcnt lgkmcnt(3)
    v_mfma_f32_16x16x32_bf16 v[164:167], v[52:55], v[116:119], v[164:167]
    s_waitcnt lgkmcnt(2)
    v_mfma_f32_16x16x32_bf16 v[164:167], v[56:59], v[120:123], v[164:167]
    s_waitcnt lgkmcnt(1)
    v_mfma_f32_16x16x32_bf16 v[164:167], v[60:63], v[124:127], v[164:167]
    s_waitcnt lgkmcnt(0)
    v_mfma_f32_16x16x32_bf16 v[164:167], v[64:67], v[128:131], v[164:167]
    ds_write_b32 v33, v22 offset:16
    s_cmp_ge_i32 s56, s53
    s_cbranch_scc1 L_pd10
L_pl10:
    ds_read_b32 v34, v32 offset:0
    s_waitcnt lgkmcnt(0)
    v_readfirstlane_b32 s56, v34
    s_cmp_ge_i32 s56, s53
    s_cbranch_scc1 L_pd10
    s_sleep 1
    s_branch L_pl10
L_pd10:
    ds_read_b128 v[36:39], v5 offset:0
    ds_read_b128 v[40:43], v6 offset:0
    ds_read_b128 v[44:47], v7 offset:0
    ds_read_b128 v[48:51], v8 offset:0
    ds_read_b128 v[52:55], v5 offset:4096
    ds_read_b128 v[56:59], v6 offset:4096
    ds_read_b128 v[60:63], v7 offset:4096
    ds_read_b128 v[64:67], v8 offset:4096
    v_mov_b32 v22, s54
    s_add_u32 s53, s53, 8
    s_add_u32 s54, s54, 8
    s_waitcnt lgkmcnt(7)
    v_mfma_f32_16x16x32_bf16 v[168:171], v[36:39], v[100:103], 0
    s_waitcnt lgkmcnt(6)
    v_mfma_f32_16x16x32_bf16 v[168:171], v[40:43], v[104:107], v[168:171]
    s_waitcnt lgkmcnt(5)
    v_mfma_f32_16x16x32_bf16 v[168:171], v[44:47], v[108:111], v[168:171]
    s_waitcnt lgkmcnt(4)
    v_mfma_f32_16x16x32_bf16 v[168:171], v[48:51], v[112:115], v[168:171]
    s_waitcnt lgkmcnt(3)
    v_mfma_f32_16x16x32_bf16 v[168:171], v[52:55], v[116:119], v[168:171]
    s_waitcnt lgkmcnt(2)
    v_mfma_f32_16x16x32_bf16 v[168:171], v[56:59], v[120:123], v[168:171]
    s_waitcnt lgkmcnt(1)
    v_mfma_f32_16x16x32_bf16 v[168:171], v[60:63], v[124:127], v[168:171]
    s_waitcnt lgkmcnt(0)
    v_mfma_f32_16x16x32_bf16 v[168:171], v[64:67], v[128:131], v[168:171]
    ds_write_b32 v33, v22 offset:16
    s_cmp_ge_i32 s56, s53
    s_cbranch_scc1 L_pd11
L_pl11:
    ds_read_b32 v34, v32 offset:0
    s_waitcnt lgkmcnt(0)
    v_readfirstlane_b32 s56, v34
    s_cmp_ge_i32 s56, s53
    s_cbranch_scc1 L_pd11
    s_sleep 1
    s_branch L_pl11
L_pd11:
    ds_read_b128 v[36:39], v5 offset:32768
    ds_read_b128 v[40:43], v6 offset:32768
    ds_read_b128 v[44:47], v7 offset:32768
    ds_read_b128 v[48:51], v8 offset:32768
    ds_read_b128 v[52:55], v5 offset:36864
    ds_read_b128 v[56:59], v6 offset:36864
    ds_read_b128 v[60:63], v7 offset:36864
    ds_read_b128 v[64:67], v8 offset:36864
    v_mov_b32 v22, s54
    s_add_u32 s53, s53, 8
    s_add_u32 s54, s54, 8
    s_waitcnt lgkmcnt(7)
    v_mfma_f32_16x16x32_bf16 v[172:175], v[36:39], v[100:103], 0
    s_waitcnt lgkmcnt(6)
    v_mfma_f32_16x16x32_bf16 v[172:175], v[40:43], v[104:107], v[172:175]
    s_waitcnt lgkmcnt(5)
    v_mfma_f32_16x16x32_bf16 v[172:175], v[44:47], v[108:111], v[172:175]
    s_waitcnt lgkmcnt(4)
    v_mfma_f32_16x16x32_bf16 v[172:175], v[48:51], v[112:115], v[172:175]
    s_waitcnt lgkmcnt(3)
    v_mfma_f32_16x16x32_bf16 v[172:175], v[52:55], v[116:119], v[172:175]
    s_waitcnt lgkmcnt(2)
    v_mfma_f32_16x16x32_bf16 v[172:175], v[56:59], v[120:123], v[172:175]
    s_waitcnt lgkmcnt(1)
    v_mfma_f32_16x16x32_bf16 v[172:175], v[60:63], v[124:127], v[172:175]
    s_waitcnt lgkmcnt(0)
    v_mfma_f32_16x16x32_bf16 v[172:175], v[64:67], v[128:131], v[172:175]
    ds_write_b32 v33, v22 offset:16
    s_cmp_ge_i32 s56, s53
    s_cbranch_scc1 L_pd12
L_pl12:
    ds_read_b32 v34, v32 offset:0
    s_waitcnt lgkmcnt(0)
    v_readfirstlane_b32 s56, v34
    s_cmp_ge_i32 s56, s53
    s_cbranch_scc1 L_pd12
    s_sleep 1
    s_branch L_pl12
L_pd12:
    ds_read_b128 v[36:39], v9 offset:0
    ds_read_b128 v[40:43], v10 offset:0
    ds_read_b128 v[44:47], v11 offset:0
    ds_read_b128 v[48:51], v12 offset:0
    ds_read_b128 v[52:55], v9 offset:4096
    ds_read_b128 v[56:59], v10 offset:4096
    ds_read_b128 v[60:63], v11 offset:4096
    ds_read_b128 v[64:67], v12 offset:4096
    v_mov_b32 v22, s54
    s_add_u32 s53, s53, 8
    s_add_u32 s54, s54, 8
    s_waitcnt lgkmcnt(7)
    v_mfma_f32_16x16x32_bf16 v[176:179], v[36:39], v[100:103], 0
    s_waitcnt lgkmcnt(6)
    v_mfma_f32_16x16x32_bf16 v[176:179], v[40:43], v[104:107], v[176:179]
    s_waitcnt lgkmcnt(5)
    v_mfma_f32_16x16x32_bf16 v[176:179], v[44:47], v[108:111], v[176:179]
    s_waitcnt lgkmcnt(4)
    v_mfma_f32_16x16x32_bf16 v[176:179], v[48:51], v[112:115], v[176:179]
    s_waitcnt lgkmcnt(3)
    v_mfma_f32_16x16x32_bf16 v[176:179], v[52:55], v[116:119], v[176:179]
    s_waitcnt lgkmcnt(2)
    v_mfma_f32_16x16x32_bf16 v[176:179], v[56:59], v[120:123], v[176:179]
    s_waitcnt lgkmcnt(1)
    v_mfma_f32_16x16x32_bf16 v[176:179], v[60:63], v[124:127], v[176:179]
    s_waitcnt lgkmcnt(0)
    v_mfma_f32_16x16x32_bf16 v[176:179], v[64:67], v[128:131], v[176:179]
    ds_write_b32 v33, v22 offset:16
    s_cmp_ge_i32 s56, s53
    s_cbranch_scc1 L_pd13
L_pl13:
    ds_read_b32 v34, v32 offset:0
    s_waitcnt lgkmcnt(0)
    v_readfirstlane_b32 s56, v34
    s_cmp_ge_i32 s56, s53
    s_cbranch_scc1 L_pd13
    s_sleep 1
    s_branch L_pl13
L_pd13:
    ds_read_b128 v[36:39], v5 offset:0
    ds_read_b128 v[40:43], v6 offset:0
    ds_read_b128 v[44:47], v7 offset:0
    ds_read_b128 v[48:51], v8 offset:0
    ds_read_b128 v[52:55], v5 offset:4096
    ds_read_b128 v[56:59], v6 offset:4096
    ds_read_b128 v[60:63], v7 offset:4096
    ds_read_b128 v[64:67], v8 offset:4096
    v_mov_b32 v22, s54
    s_add_u32 s53, s53, 8
    s_add_u32 s54, s54, 8
    s_waitcnt lgkmcnt(7)
    v_mfma_f32_16x16x32_bf16 v[180:183], v[36:39], v[100:103], 0
    s_waitcnt lgkmcnt(6)
    v_mfma_f32_16x16x32_bf16 v[180:183], v[40:43], v[104:107], v[180:183]
    s_waitcnt lgkmcnt(5)
    v_mfma_f32_16x16x32_bf16 v[180:183], v[44:47], v[108:111], v[180:183]
    s_waitcnt lgkmcnt(4)
    v_mfma_f32_16x16x32_bf16 v[180:183], v[48:51], v[112:115], v[180:183]
    s_waitcnt lgkmcnt(3)
    v_mfma_f32_16x16x32_bf16 v[180:183], v[52:55], v[116:119], v[180:183]
    s_waitcnt lgkmcnt(2)
    v_mfma_f32_16x16x32_bf16 v[180:183], v[56:59], v[120:123], v[180:183]
    s_waitcnt lgkmcnt(1)
    v_mfma_f32_16x16x32_bf16 v[180:183], v[60:63], v[124:127], v[180:183]
    s_waitcnt lgkmcnt(0)
    v_mfma_f32_16x16x32_bf16 v[180:183], v[64:67], v[128:131], v[180:183]
    ds_write_b32 v33, v22 offset:16
    s_cmp_ge_i32 s56, s53
    s_cbranch_scc1 L_pd14
L_pl14:
    ds_read_b32 v34, v32 offset:0
    s_waitcnt lgkmcnt(0)
    v_readfirstlane_b32 s56, v34
    s_cmp_ge_i32 s56, s53
    s_cbranch_scc1 L_pd14
    s_sleep 1
    s_branch L_pl14
L_pd14:
    ds_read_b128 v[36:39], v5 offset:32768
    ds_read_b128 v[40:43], v6 offset:32768
    ds_read_b128 v[44:47], v7 offset:32768
    ds_read_b128 v[48:51], v8 offset:32768
    ds_read_b128 v[52:55], v5 offset:36864
    ds_read_b128 v[56:59], v6 offset:36864
    ds_read_b128 v[60:63], v7 offset:36864
    ds_read_b128 v[64:67], v8 offset:36864
    v_mov_b32 v22, s54
    s_add_u32 s53, s53, 8
    s_add_u32 s54, s54, 8
    s_waitcnt lgkmcnt(7)
    v_mfma_f32_16x16x32_bf16 v[184:187], v[36:39], v[100:103], 0
    s_waitcnt lgkmcnt(6)
    v_mfma_f32_16x16x32_bf16 v[184:187], v[40:43], v[104:107], v[184:187]
    s_waitcnt lgkmcnt(5)
    v_mfma_f32_16x16x32_bf16 v[184:187], v[44:47], v[108:111], v[184:187]
    s_waitcnt lgkmcnt(4)
    v_mfma_f32_16x16x32_bf16 v[184:187], v[48:51], v[112:115], v[184:187]
    s_waitcnt lgkmcnt(3)
    v_mfma_f32_16x16x32_bf16 v[184:187], v[52:55], v[116:119], v[184:187]
    s_waitcnt lgkmcnt(2)
    v_mfma_f32_16x16x32_bf16 v[184:187], v[56:59], v[120:123], v[184:187]
    s_waitcnt lgkmcnt(1)
    v_mfma_f32_16x16x32_bf16 v[184:187], v[60:63], v[124:127], v[184:187]
    s_waitcnt lgkmcnt(0)
    v_mfma_f32_16x16x32_bf16 v[184:187], v[64:67], v[128:131], v[184:187]
    ds_write_b32 v33, v22 offset:16
    s_cmp_ge_i32 s56, s53
    s_cbranch_scc1 L_pd15
L_pl15:
    ds_read_b32 v34, v32 offset:0
    s_waitcnt lgkmcnt(0)
    v_readfirstlane_b32 s56, v34
    s_cmp_ge_i32 s56, s53
    s_cbranch_scc1 L_pd15
    s_sleep 1
    s_branch L_pl15
L_pd15:
    ds_read_b128 v[36:39], v9 offset:0
    ds_read_b128 v[40:43], v10 offset:0
    ds_read_b128 v[44:47], v11 offset:0
    ds_read_b128 v[48:51], v12 offset:0
    ds_read_b128 v[52:55], v9 offset:4096
    ds_read_b128 v[56:59], v10 offset:4096
    ds_read_b128 v[60:63], v11 offset:4096
    ds_read_b128 v[64:67], v12 offset:4096
    v_mov_b32 v22, s54
    s_add_u32 s53, s53, 8
    s_add_u32 s54, s54, 8
    s_waitcnt lgkmcnt(7)
    v_mfma_f32_16x16x32_bf16 v[188:191], v[36:39], v[100:103], 0
    s_waitcnt lgkmcnt(6)
    v_mfma_f32_16x16x32_bf16 v[188:191], v[40:43], v[104:107], v[188:191]
    s_waitcnt lgkmcnt(5)
    v_mfma_f32_16x16x32_bf16 v[188:191], v[44:47], v[108:111], v[188:191]
    s_waitcnt lgkmcnt(4)
    v_mfma_f32_16x16x32_bf16 v[188:191], v[48:51], v[112:115], v[188:191]
    s_waitcnt lgkmcnt(3)
    v_mfma_f32_16x16x32_bf16 v[188:191], v[52:55], v[116:119], v[188:191]
    s_waitcnt lgkmcnt(2)
    v_mfma_f32_16x16x32_bf16 v[188:191], v[56:59], v[120:123], v[188:191]
    s_waitcnt lgkmcnt(1)
    v_mfma_f32_16x16x32_bf16 v[188:191], v[60:63], v[124:127], v[188:191]
    s_waitcnt lgkmcnt(0)
    v_mfma_f32_16x16x32_bf16 v[188:191], v[64:67], v[128:131], v[188:191]
    ds_write_b32 v33, v22 offset:16
    s_cmp_ge_i32 s56, s53
    s_cbranch_scc1 L_pd16
L_pl16:
    ds_read_b32 v34, v32 offset:0
    s_waitcnt lgkmcnt(0)
    v_readfirstlane_b32 s56, v34
    s_cmp_ge_i32 s56, s53
    s_cbranch_scc1 L_pd16
    s_sleep 1
    s_branch L_pl16
L_pd16:
    ds_read_b128 v[36:39], v5 offset:0
    ds_read_b128 v[40:43], v6 offset:0
    ds_read_b128 v[44:47], v7 offset:0
    ds_read_b128 v[48:51], v8 offset:0
    ds_read_b128 v[52:55], v5 offset:4096
    ds_read_b128 v[56:59], v6 offset:4096
    ds_read_b128 v[60:63], v7 offset:4096
    ds_read_b128 v[64:67], v8 offset:4096
    v_mov_b32 v22, 128
    s_add_u32 s53, s53, 8
    s_add_u32 s54, s54, 8
    s_waitcnt lgkmcnt(7)
    v_mfma_f32_16x16x32_bf16 v[192:195], v[36:39], v[100:103], 0
    s_waitcnt lgkmcnt(6)
    v_mfma_f32_16x16x32_bf16 v[192:195], v[40:43], v[104:107], v[192:195]
    s_waitcnt lgkmcnt(5)
    v_mfma_f32_16x16x32_bf16 v[192:195], v[44:47], v[108:111], v[192:195]
    s_waitcnt lgkmcnt(4)
    v_mfma_f32_16x16x32_bf16 v[192:195], v[48:51], v[112:115], v[192:195]
    s_waitcnt lgkmcnt(3)
    v_mfma_f32_16x16x32_bf16 v[192:195], v[52:55], v[116:119], v[192:195]
    s_waitcnt lgkmcnt(2)
    v_mfma_f32_16x16x32_bf16 v[192:195], v[56:59], v[120:123], v[192:195]
    s_waitcnt lgkmcnt(1)
    v_mfma_f32_16x16x32_bf16 v[192:195], v[60:63], v[124:127], v[192:195]
    s_waitcnt lgkmcnt(0)
    v_mfma_f32_16x16x32_bf16 v[192:195], v[64:67], v[128:131], v[192:195]
    ds_write_b32 v33, v22 offset:16
    v_max3_f32 v20, v132, v133, v134
    v_max3_f32 v22, v135, v136, v137
    v_max3_f32 v20, v20, v138, v139
    v_max3_f32 v22, v22, v140, v141
    v_max3_f32 v20, v20, v142, v143
    v_max3_f32 v22, v22, v144, v145
    v_max3_f32 v20, v20, v146, v147
    v_max3_f32 v22, v22, v148, v149
    v_max3_f32 v20, v20, v150, v151
    v_max3_f32 v22, v22, v152, v153
    v_max3_f32 v20, v20, v154, v155
    v_max3_f32 v22, v22, v156, v157
    v_max3_f32 v20, v20, v158, v159
    v_max3_f32 v22, v22, v160, v161
    v_max3_f32 v20, v20, v162, v163
    v_max3_f32 v22, v22, v164, v165
    v_max3_f32 v20, v20, v166, v167
    v_max3_f32 v22, v22, v168, v169
    v_max3_f32 v20, v20, v170, v171
    v_max3_f32 v22, v22, v172, v173
    v_max3_f32 v20, v20, v174, v175
    v_max3_f32 v22, v22, v176, v177
    v_max3_f32 v20, v20, v178, v179
    v_max3_f32 v22, v22, v180, v181
    v_max3_f32 v20, v20, v182, v183
    v_max3_f32 v22, v22, v184, v185
    v_max3_f32 v20, v20, v186, v187
    v_max3_f32 v22, v22, v188, v189
    v_max3_f32 v20, v20, v190, v191
    v_max3_f32 v22, v22, v192, v193
    v_max3_f32 v20, v20, v194, v195
    v_max_f32 v20, v20, v22
    v_mov_b32 v22, v20
    v_lshlrev_b32 v23, 4, v18
    v_add_u32 v23, 131072, v23
    v_permlane32_swap_b32 v20, v22
    v_max_f32 v20, v20, v22
    v_mov_b32 v22, v20
    v_lshl_add_u32 v24, v31, 2, v23
    v_mov_b32 v14, 1
    v_permlane16_swap_b32 v20, v22
    v_max_f32 v20, v20, v22
    ds_write_b32 v24, v20
    s_waitcnt lgkmcnt(0)
    s_mov_b64 exec, 1
    ds_add_u32 v32, v14 offset:32
    s_mov_b64 exec, -1
    s_lshr_b32 s52, s46, 1
    s_lshl_b32 s52, s52, 10
    s_and_b32 s53, s46, 1
    s_lshl_b32 s53, s53, 3
    s_add_u32 s52, s52, s53
    v_add_u32 v25, s52, v15
L_pl17:
    ds_read_b32 v34, v32 offset:32
    s_waitcnt lgkmcnt(0)
    v_readfirstlane_b32 s54, v34
    s_cmp_ge_i32 s54, 4
    s_cbranch_scc0 L_pl17
L_pd17:
    ds_read_b128 v[36:39], v23
    s_waitcnt lgkmcnt(0)
    v_max3_f32 v20, v36, v37, v38
    v_max_f32 v20, v20, v39
    v_mul_f32 v20, s45, v20
    v_fma_f32 v132, v132, s45, -v20
    v_fma_f32 v133, v133, s45, -v20
    v_fma_f32 v134, v134, s45, -v20
    v_fma_f32 v135, v135, s45, -v20
    v_exp_f32 v132, v132
    v_exp_f32 v133, v133
    v_exp_f32 v134, v134
    v_exp_f32 v135, v135
    v_fma_f32 v136, v136, s45, -v20
    v_fma_f32 v137, v137, s45, -v20
    v_fma_f32 v138, v138, s45, -v20
    v_fma_f32 v139, v139, s45, -v20
    v_exp_f32 v136, v136
    v_exp_f32 v137, v137
    v_exp_f32 v138, v138
    v_exp_f32 v139, v139
    v_cvt_pk_bf16_f32 v196, v132, v133
    v_cvt_pk_bf16_f32 v197, v134, v135
    v_add_f32 v21, v132, v133
    v_add_f32 v22, v134, v135
    ds_write_b64 v25, v[196:197] offset:0
    v_fma_f32 v140, v140, s45, -v20
    v_fma_f32 v141, v141, s45, -v20
    v_fma_f32 v142, v142, s45, -v20
    v_fma_f32 v143, v143, s45, -v20
    v_exp_f32 v140, v140
    v_exp_f32 v141, v141
    v_exp_f32 v142, v142
    v_exp_f32 v143, v143
    v_cvt_pk_bf16_f32 v198, v136, v137
    v_cvt_pk_bf16_f32 v199, v138, v139
    v_add_f32 v21, v21, v136
    v_add_f32 v22, v22, v137
    v_add_f32 v21, v21, v138
    v_add_f32 v22, v22, v139
    ds_write_b64 v25, v[198:199] offset:2048
    v_fma_f32 v144, v144, s45, -v20
    v_fma_f32 v145, v145, s45, -v20
    v_fma_f32 v146, v146, s45, -v20
    v_fma_f32 v147, v147, s45, -v20
    v_exp_f32 v144, v144
    v_exp_f32 v145, v145
    v_exp_f32 v146, v146
    v_exp_f32 v147, v147
    v_cvt_pk_bf16_f32 v200, v140, v141
    v_cvt_pk_bf16_f32 v201, v142, v143
    v_add_f32 v21, v21, v140
    v_add_f32 v22, v22, v141
    v_add_f32 v21, v21, v142
    v_add_f32 v22, v22, v143
    ds_write_b64 v25, v[200:201] offset:4096
    v_fma_f32 v148, v148, s45, -v20
    v_fma_f32 v149, v149, s45, -v20
    v_fma_f32 v150, v150, s45, -v20
    v_fma_f32 v151, v151, s45, -v20
    v_exp_f32 v148, v148
    v_exp_f32 v149, v149
    v_exp_f32 v150, v150
    v_exp_f32 v151, v151
    v_cvt_pk_bf16_f32 v202, v144, v145
    v_cvt_pk_bf16_f32 v203, v146, v147
    v_add_f32 v21, v21, v144
    v_add_f32 v22, v22, v145
    v_add_f32 v21, v21, v146
    v_add_f32 v22, v22, v147
    ds_write_b64 v25, v[202:203] offset:6144
    v_fma_f32 v152, v152, s45, -v20
    v_fma_f32 v153, v153, s45, -v20
    v_fma_f32 v154, v154, s45, -v20
    v_fma_f32 v155, v155, s45, -v20
    v_exp_f32 v152, v152
    v_exp_f32 v153, v153
    v_exp_f32 v154, v154
    v_exp_f32 v155, v155
    v_cvt_pk_bf16_f32 v204, v148, v149
    v_cvt_pk_bf16_f32 v205, v150, v151
    v_add_f32 v21, v21, v148
    v_add_f32 v22, v22, v149
    v_add_f32 v21, v21, v150
    v_add_f32 v22, v22, v151
    ds_write_b64 v25, v[204:205] offset:8192
    v_fma_f32 v156, v156, s45, -v20
    v_fma_f32 v157, v157, s45, -v20
    v_fma_f32 v158, v158, s45, -v20
    v_fma_f32 v159, v159, s45, -v20
    v_exp_f32 v156, v156
    v_exp_f32 v157, v157
    v_exp_f32 v158, v158
    v_exp_f32 v159, v159
    v_cvt_pk_bf16_f32 v206, v152, v153
    v_cvt_pk_bf16_f32 v207, v154, v155
    v_add_f32 v21, v21, v152
    v_add_f32 v22, v22, v153
    v_add_f32 v21, v21, v154
    v_add_f32 v22, v22, v155
    ds_write_b64 v25, v[206:207] offset:10240
    v_fma_f32 v160, v160, s45, -v20
    v_fma_f32 v161, v161, s45, -v20
    v_fma_f32 v162, v162, s45, -v20
    v_fma_f32 v163, v163, s45, -v20
    v_exp_f32 v160, v160
    v_exp_f32 v161, v161
    v_exp_f32 v162, v162
    v_exp_f32 v163, v163
    v_cvt_pk_bf16_f32 v208, v156, v157
    v_cvt_pk_bf16_f32 v209, v158, v159
    v_add_f32 v21, v21, v156
    v_add_f32 v22, v22, v157
    v_add_f32 v21, v21, v158
    v_add_f32 v22, v22, v159
    ds_write_b64 v25, v[208:209] offset:12288
    v_fma_f32 v164, v164, s45, -v20
    v_fma_f32 v165, v165, s45, -v20
    v_fma_f32 v166, v166, s45, -v20
    v_fma_f32 v167, v167, s45, -v20
    v_exp_f32 v164, v164
    v_exp_f32 v165, v165
    v_exp_f32 v166, v166
    v_exp_f32 v167, v167
    v_cvt_pk_bf16_f32 v210, v160, v161
    v_cvt_pk_bf16_f32 v211, v162, v163
    v_add_f32 v21, v21, v160
    v_add_f32 v22, v22, v161
    v_add_f32 v21, v21, v162
    v_add_f32 v22, v22, v163
    ds_write_b64 v25, v[210:211] offset:14336
    v_fma_f32 v168, v168, s45, -v20
    v_fma_f32 v169, v169, s45, -v20
    v_fma_f32 v170, v170, s45, -v20
    v_fma_f32 v171, v171, s45, -v20
    v_exp_f32 v168, v168
    v_exp_f32 v169, v169
    v_exp_f32 v170, v170
    v_exp_f32 v171, v171
    v_cvt_pk_bf16_f32 v212, v164, v165
    v_cvt_pk_bf16_f32 v213, v166, v167
    v_add_f32 v21, v21, v164
    v_add_f32 v22, v22, v165
    v_add_f32 v21, v21, v166
    v_add_f32 v22, v22, v167
    ds_write_b64 v25, v[212:213] offset:16384
    v_fma_f32 v172, v172, s45, -v20
    v_fma_f32 v173, v173, s45, -v20
    v_fma_f32 v174, v174, s45, -v20
    v_fma_f32 v175, v175, s45, -v20
    v_exp_f32 v172, v172
    v_exp_f32 v173, v173
    v_exp_f32 v174, v174
    v_exp_f32 v175, v175
    v_cvt_pk_bf16_f32 v214, v168, v169
    v_cvt_pk_bf16_f32 v215, v170, v171
    v_add_f32 v21, v21, v168
    v_add_f32 v22, v22, v169
    v_add_f32 v21, v21, v170
    v_add_f32 v22, v22, v171
    ds_write_b64 v25, v[214:215] offset:18432
    v_fma_f32 v176, v176, s45, -v20
    v_fma_f32 v177, v177, s45, -v20
    v_fma_f32 v178, v178, s45, -v20
    v_fma_f32 v179, v179, s45, -v20
    v_exp_f32 v176, v176
    v_exp_f32 v177, v177
    v_exp_f32 v178, v178
    v_exp_f32 v179, v179
    v_cvt_pk_bf16_f32 v216, v172, v173
    v_cvt_pk_bf16_f32 v217, v174, v175
    v_add_f32 v21, v21, v172
    v_add_f32 v22, v22, v173
    v_add_f32 v21, v21, v174
    v_add_f32 v22, v22, v175
    ds_write_b64 v25, v[216:217] offset:20480
    v_fma_f32 v180, v180, s45, -v20
    v_fma_f32 v181, v181, s45, -v20
    v_fma_f32 v182, v182, s45, -v20
    v_fma_f32 v183, v183, s45, -v20
    v_exp_f32 v180, v180
    v_exp_f32 v181, v181
    v_exp_f32 v182, v182
    v_exp_f32 v183, v183
    v_cvt_pk_bf16_f32 v218, v176, v177
    v_cvt_pk_bf16_f32 v219, v178, v179
    v_add_f32 v21, v21, v176
    v_add_f32 v22, v22, v177
    v_add_f32 v21, v21, v178
    v_add_f32 v22, v22, v179
    ds_write_b64 v25, v[218:219] offset:22528
    v_fma_f32 v184, v184, s45, -v20
    v_fma_f32 v185, v185, s45, -v20
    v_fma_f32 v186, v186, s45, -v20
    v_fma_f32 v187, v187, s45, -v20
    v_exp_f32 v184, v184
    v_exp_f32 v185, v185
    v_exp_f32 v186, v186
    v_exp_f32 v187, v187
    v_cvt_pk_bf16_f32 v220, v180, v181
    v_cvt_pk_bf16_f32 v221, v182, v183
    v_add_f32 v21, v21, v180
    v_add_f32 v22, v22, v181
    v_add_f32 v21, v21, v182
    v_add_f32 v22, v22, v183
    ds_write_b64 v25, v[220:221] offset:24576
    v_fma_f32 v188, v188, s45, -v20
    v_fma_f32 v189, v189, s45, -v20
    v_fma_f32 v190, v190, s45, -v20
    v_fma_f32 v191, v191, s45, -v20
    v_exp_f32 v188, v188
    v_exp_f32 v189, v189
    v_exp_f32 v190, v190
    v_exp_f32 v191, v191
    v_cvt_pk_bf16_f32 v222, v184, v185
    v_cvt_pk_bf16_f32 v223, v186, v187
    v_add_f32 v21, v21, v184
    v_add_f32 v22, v22, v185
    v_add_f32 v21, v21, v186
    v_add_f32 v22, v22, v187
    ds_write_b64 v25, v[222:223] offset:26624
    v_fma_f32 v192, v192, s45, -v20
    v_fma_f32 v193, v193, s45, -v20
    v_fma_f32 v194, v194, s45, -v20
    v_fma_f32 v195, v195, s45, -v20
    v_exp_f32 v192, v192
    v_exp_f32 v193, v193
    v_exp_f32 v194, v194
    v_exp_f32 v195, v195
    v_cvt_pk_bf16_f32 v224, v188, v189
    v_cvt_pk_bf16_f32 v225, v190, v191
    v_add_f32 v21, v21, v188
    v_add_f32 v22, v22, v189
    v_add_f32 v21, v21, v190
    v_add_f32 v22, v22, v191
    ds_write_b64 v25, v[224:225] offset:28672
    s_nop 0
    v_cvt_pk_bf16_f32 v226, v192, v193
    v_cvt_pk_bf16_f32 v227, v194, v195
    v_add_f32 v21, v21, v192
    v_add_f32 v22, v22, v193
    v_add_f32 v21, v21, v194
    v_add_f32 v22, v22, v195
    ds_write_b64 v25, v[226:227] offset:30720
    v_add_f32 v21, v21, v22
    v_mov_b32 v22, v21
    s_nop 1
    v_permlane32_swap_b32 v21, v22
    v_add_f32 v21, v21, v22
    v_mov_b32 v22, v21
    s_nop 1
    v_permlane16_swap_b32 v21, v22
    v_add_f32 v21, v21, v22
    ds_write_b32 v24, v21 offset:256
    s_waitcnt vmcnt(0) lgkmcnt(0)
    s_mov_b64 exec, 1
    ds_add_u32 v32, v14 offset:36
    s_mov_b64 exec, -1
    v_readfirstlane_b32 s51, v27
    v_readfirstlane_b32 s50, v28
    v_mov_b32 v76, 0
    v_mov_b32 v77, 0
    v_mov_b32 v78, 0
    v_mov_b32 v79, 0
    v_mov_b32 v80, 0
    v_mov_b32 v81, 0
    v_mov_b32 v82, 0
    v_mov_b32 v83, 0
    s_add_u32 s51, s51, 0x9e3779b1
    s_add_u32 s50, s50, 0x9e3779b1
    s_mov_b32 s60, 0
    s_mov_b32 s61, 32768
    s_mov_b32 s53, 134
L_pl18:
    ds_read_b32 v34, v32 offset:36
    s_waitcnt lgkmcnt(0)
    v_readfirstlane_b32 s54, v34
    s_cmp_ge_i32 s54, 4
    s_cbranch_scc0 L_pl18
L_pd18:
    ds_read_b128 v[84:87], v23 offset:256
    s_waitcnt lgkmcnt(0)
    v_add_f32 v21, v84, v85
    v_add_f32 v22, v86, v87
    v_add_f32 v21, v21, v22
    v_log_f32 v29, v21
    v_rcp_f32 v30, v21
    v_mov_b32 v16, v15
    v_add_f32 v29, v29, v20
    v_mov_b32 v108, v30
    v_mov_b32 v100, 0
    v_mov_b32 v101, 0
    v_mov_b32 v102, 0
    v_mov_b32 v103, 0
    v_mov_b32 v104, 0
    v_mov_b32 v105, 0
    v_mov_b32 v106, 0
    v_mov_b32 v107, 0
    s_mov_b32 s59, s48
    s_mov_b32 s41, 16
L_vloop:
    v_add_u32 v14, s61, v13
    ds_read_b128 v[68:71], v16 offset:0
    ds_read_b128 v[72:75], v16 offset:1024
    s_sub_u32 s54, s53, 2
    v_mov_b32 v22, s54
    s_cmp_ge_i32 s56, s53
    s_cbranch_scc1 L_pd19
L_pl19:
    ds_read_b32 v34, v32 offset:0
    s_waitcnt lgkmcnt(0)
    v_readfirstlane_b32 s56, v34
    s_cmp_ge_i32 s56, s53
    s_cbranch_scc1 L_pd19
    s_sleep 1
    s_branch L_pl19
L_pd19:
    ds_read_b64_tr_b16 v[36:37], v14 offset:0
    ds_read_b64_tr_b16 v[38:39], v14 offset:4096
    ds_read_b64_tr_b16 v[40:41], v14 offset:8
    ds_read_b64_tr_b16 v[42:43], v14 offset:4104
    ds_read_b64_tr_b16 v[44:45], v14 offset:8192
    ds_read_b64_tr_b16 v[46:47], v14 offset:12288
    ds_read_b64_tr_b16 v[48:49], v14 offset:8200
    ds_read_b64_tr_b16 v[50:51], v14 offset:12296
    s_add_u32 s53, s53, 4
    s_add_u32 s61, s61, 16384
    s_cmp_ge_u32 s61, 98304
    s_cselect_b32 s61, 0, s61
    s_add_u32 s60, s60, 1
    s_cmp_lg_u32 s60, s41
    s_waitcnt lgkmcnt(6)
    v_mfma_f32_16x16x32_bf16 v[76:79], v[36:39], v[68:71], v[76:79]
    s_waitcnt lgkmcnt(4)
    v_mfma_f32_16x16x32_bf16 v[80:83], v[40:43], v[68:71], v[80:83]
    s_waitcnt lgkmcnt(2)
    v_mfma_f32_16x16x32_bf16 v[76:79], v[44:47], v[72:75], v[76:79]
    s_waitcnt lgkmcnt(0)
    v_mfma_f32_16x16x32_bf16 v[80:83], v[48:51], v[72:75], v[80:83]
    s_cbranch_scc0 L_emit
    ds_write_b32 v33, v22 offset:16
    v_add_u32 v16, 0x800, v16
    s_cmp_lt_u32 s60, 16
    s_cbranch_scc1 L_vloop
    s_cmp_eq_u32 s60, 18
    s_cbranch_scc1 L_flag
    s_cmp_eq_u32 s60, 24
    s_cbranch_scc1 L_pollf
    s_cmp_eq_u32 s60, 28
    s_cbranch_scc1 L_pre
    s_cmp_lg_u32 s60, 26
    s_cbranch_scc1 L_vloop
    s_waitcnt vmcnt(0)
    s_add_u32 s52, s51, s42
    v_cmp_ne_u32 vcc, s52, v3
    s_cmp_lg_u64 vcc, 0
    s_cbranch_scc1 L_vloop
    s_mov_b32 s55, 1
    buffer_load_dwordx4 v[96:99], v17, s[28:31], s49 offen nt
    s_branch L_vloop
L_pollf:
    buffer_load_dwordx2 v[2:3], v1, s[36:39], s32 offen nt
    s_branch L_vloop
L_flag:
    s_waitcnt vmcnt(0)
    s_mov_b64 exec, 0xffff
    buffer_store_dwordx2 v[92:93], v1, s[36:39], s33 offen
    s_mov_b64 exec, -1
    s_branch L_vloop
L_slow_fail:
    s_add_u32 s55, s55, 1
    s_cmp_lt_u32 s55, 8
    s_cbranch_scc1 L_slow
    s_cmp_lg_u32 s43, 0
    s_cbranch_scc1 L_rel0
    s_mov_b32 s43, 1
    s_waitcnt vmcnt(0)
    buffer_wbl2 sc1
    s_lshl_b32 s52, s33, 3
    buffer_store_dwordx4 v[84:87], v26, s[36:39], s52 offen sc1
    s_add_u32 s52, s50, 16
    v_mov_b32 v93, s52
    s_waitcnt vmcnt(0)
    s_mov_b64 exec, 0xffff
    buffer_store_dwordx2 v[92:93], v1, s[36:39], s33 offen sc1
    s_mov_b64 exec, -1
L_rel0:
    s_sleep 2
L_slow:
    buffer_load_dwordx2 v[2:3], v1, s[36:39], s32 offen sc1
    s_waitcnt vmcnt(0)
    s_add_u32 s52, s51, s42
    s_add_u32 s54, s51, 16
    v_cmp_eq_u32 vcc, s52, v3
    v_cmp_eq_u32 s[20:21], s54, v3
    s_or_b64 vcc, vcc, s[20:21]
    s_cmp_lg_u64 vcc, -1
    s_cbranch_scc1 L_slow_fail
    s_cmp_lg_u64 s[20:21], 0
    s_cbranch_scc1 L_slow_far
    buffer_load_dwordx4 v[96:99], v17, s[28:31], s49 offen sc1
    s_branch L_ok
L_slow_far:
    s_lshl_b32 s52, s32, 3
    buffer_load_dwordx4 v[96:99], v26, s[36:39], s52 offen sc1
    s_cmp_lg_u32 s43, 0
    s_cbranch_scc1 L_rel1
    s_mov_b32 s43, 1
    s_waitcnt vmcnt(0)
    buffer_wbl2 sc1
    s_lshl_b32 s52, s33, 3
    buffer_store_dwordx4 v[84:87], v26, s[36:39], s52 offen sc1
    s_add_u32 s52, s50, 16
    v_mov_b32 v93, s52
    s_waitcnt vmcnt(0)
    s_mov_b64 exec, 0xffff
    buffer_store_dwordx2 v[92:93], v1, s[36:39], s33 offen sc1
    s_mov_b64 exec, -1
L_rel1:
    s_branch L_ok
L_pre:
    s_cmp_eq_u32 s55, 0
    s_cbranch_scc1 L_slow
L_ok:
    v_max_f32 v22, v29, v2
    v_sub_f32 v23, v29, v22
    v_sub_f32 v24, v2, v22
    v_exp_f32 v23, v23
    v_exp_f32 v24, v24
    v_mov_b32 v94, s51
    v_add_f32 v22, v23, v24
    v_rcp_f32 v22, v22
    v_mul_f32 v23, v23, v30
    v_mul_f32 v108, v23, v22
    v_mul_f32 v24, v24, v22
    v_mov_b32 v95, s51
    s_waitcnt vmcnt(0)
    v_lshlrev_b32 v100, 16, v96
    v_and_b32 v101, 0xffff0000, v96
    v_lshlrev_b32 v102, 16, v97
    v_and_b32 v103, 0xffff0000, v97
    v_lshlrev_b32 v104, 16, v98
    v_and_b32 v105, 0xffff0000, v98
    v_lshlrev_b32 v106, 16, v99
    v_and_b32 v107, 0xffff0000, v99
    v_mul_f32 v100, v24, v100
    v_mul_f32 v101, v24, v101
    v_mul_f32 v102, v24, v102
    v_mul_f32 v103, v24, v103
    v_mul_f32 v104, v24, v104
    v_mul_f32 v105, v24, v105
    v_mul_f32 v106, v24, v106
    v_mul_f32 v107, v24, v107
    s_mov_b64 exec, 15
    buffer_store_dwordx2 v[94:95], v4, s[36:39], s34 offen
    s_mov_b64 exec, -1
    s_branch L_vloop
L_emit:
    ds_write_b32 v33, v22 offset:16
    v_mov_b32 v16, v15
    s_cmp_eq_u32 s60, 32
    s_nop 1
    v_fma_f32 v84, v76, v108, v100
    v_fma_f32 v85, v77, v108, v101
    v_fma_f32 v86, v78, v108, v102
    v_fma_f32 v87, v79, v108, v103
    v_fma_f32 v88, v80, v108, v104
    v_fma_f32 v89, v81, v108, v105
    v_fma_f32 v90, v82, v108, v106
    v_fma_f32 v91, v83, v108, v107
    v_cvt_pk_bf16_f32 v84, v84, v85
    v_cvt_pk_bf16_f32 v85, v86, v87
    v_cvt_pk_bf16_f32 v86, v88, v89
    v_cvt_pk_bf16_f32 v87, v90, v91
    buffer_store_dwordx4 v[84:87], v17, s[28:31], s59 offen
    s_cbranch_scc1 L_end
    s_mov_b32 s59, s49
    v_mov_b32 v92, v29
    s_add_u32 s52, s50, s42
    v_mov_b32 v93, s52
    s_mov_b32 s41, 32
    v_mov_b32 v76, 0
    v_mov_b32 v77, 0
    v_mov_b32 v78, 0
    v_mov_b32 v79, 0
    v_mov_b32 v80, 0
    v_mov_b32 v81, 0
    v_mov_b32 v82, 0
    v_mov_b32 v83, 0
    s_branch L_vloop
L_ctrl:
    s_mov_b32 s36, s12
    s_mov_b32 s37, s13
    s_mov_b32 s38, 256
    s_mov_b32 s39, 0x20000
    s_and_b32 s50, s2, 7
    s_lshl_b32 s50, s50, 5
    s_lshr_b32 s51, s2, 3
    s_add_u32 s51, s51, s50
    v_and_b32 v2, 31, v0
    v_and_b32 v3, 63, v0
    v_lshlrev_b32 v3, 8, v3
    s_mov_b32 s54, 1
    s_mov_b32 s55, 8
L_c0:
    ds_read_b32 v34, v32
    s_waitcnt lgkmcnt(0)
    v_readfirstlane_b32 s56, v34
    s_cmp_ge_i32 s56, s55
    s_cbranch_scc1 L_c1
    s_sleep 1
    s_branch L_c0
L_c1:
    v_mov_b32 v6, s54
    buffer_load_ubyte v7, v2, s[36:39], s50 offen nt
    buffer_store_byte v6, v3, s[36:39], s51 offen
    s_waitcnt vmcnt(1)
    v_cmp_le_u32 vcc, s54, v7
    s_bcnt1_i32_b32 s57, vcc_lo
    s_cmp_ge_u32 s57, 16
    s_cselect_b32 s57, 1, 0
    v_mov_b32 v8, s57
    ds_write_b32 v32, v8 offset:4
    s_add_u32 s54, s54, 1
    s_add_u32 s55, s55, 8
    s_cmp_lt_u32 s55, 250
    s_cbranch_scc1 L_c0
L_end:
    s_endpgm
.section .rodata,"a"
.p2align 6
.amdhsa_kernel standalone__softmax_full_bidir__sampling_kernel
  .amdhsa_next_free_vgpr 228
  .amdhsa_next_free_sgpr 64
  .amdhsa_accum_offset 228
  .amdhsa_group_segment_fixed_size 0
  .amdhsa_kernarg_size 48
  .amdhsa_user_sgpr_count 2
  .amdhsa_user_sgpr_kernarg_segment_ptr 1
  .amdhsa_system_sgpr_workgroup_id_x 1
.end_amdhsa_kernel
```
